```python
import torch

def _softmax(x, axis=-1):
    return torch.softmax(x, dim=axis)
def _gelu(x):
    return torch.nn.functional.gelu(x, approximate="tanh")
def _silu(x):
    return torch.nn.functional.silu(x)
def _sigmoid(x):
    return torch.sigmoid(x)
def _layernorm(x, axis=-1, eps=1e-5):
    m = x.mean(dim=axis, keepdim=True)
    v = x.var(dim=axis, keepdim=True, unbiased=False)
    return (x - m) / torch.sqrt(v + eps)
def _scatter_add(tgt, idx, src, axis=0):
    return tgt.clone().index_add_(axis, idx, src)
def _segment_sum(src, seg, n):
    out = torch.zeros((n,) + src.shape[1:], dtype=src.dtype)
    return out.index_add_(0, seg, src)
def _pad(x, pw):
    flat = tuple(v for pair in reversed(pw) for v in pair)
    return torch.nn.functional.pad(x, flat)

kernel_name = 'standalone__gqa_softmax__decode'

def setup_inputs():

    _w = (lambda a: (lambda t: t.to(torch.bfloat16) if t.is_floating_point() else t)(torch.as_tensor(a)))
    B, Hq, Hkv, Sq, Sk, D = 4, 16, 8, 1, 16384, 256
    return {
        "q": _w((lambda *s: torch.randn(*s, dtype=torch.bfloat16) * 0.8)(B, Hq, Sq, D)),
        "k": _w((lambda *s: torch.randn(*s, dtype=torch.bfloat16) * 0.8)(B, Hkv, Sk, D)),
        "v": _w((lambda *s: torch.randn(*s, dtype=torch.bfloat16) * 0.05)(B, Hkv, Sk, D)),
    }

def reference(q, k, v):
    B, Hq, Sq, D = q.shape
    Hkv = k.shape[1]
    rep = Hq // Hkv
    k = (lambda x, n, axis: torch.repeat_interleave(x, n, dim=axis))(k, rep, axis=1)
    v = (lambda x, n, axis: torch.repeat_interleave(x, n, dim=axis))(v, rep, axis=1)
    scale = D ** -0.5
    scores = torch.einsum("bhqd,bhkd->bhqk", q, k) * scale
    p = _softmax(scores, axis=-1)
    return torch.einsum("bhqk,bhkd->bhqd", p, v)
```

```asm
; @launch grid=(256,1,1) block=(256,1,1) lds=98304
.amdgcn_target "amdgcn-amd-amdhsa--gfx950"
.text
.globl standalone__gqa_softmax__decode_kernel
.p2align 8
.type standalone__gqa_softmax__decode_kernel,@function
standalone__gqa_softmax__decode_kernel:
s_cmp_ge_u32 s2, 256
s_cbranch_scc1 L_end
s_load_dwordx8 s[4:11], s[0:1], 0
s_load_dwordx4 s[12:15], s[0:1], 32
v_and_b32 v1, 63, v0
v_lshrrev_b32 v8, 6, v0
v_lshlrev_b32 v5, 4, v1
v_lshl_add_u32 v5, v8, 13, v5
v_readfirstlane_b32 s3, v8
v_and_b32 v9, 32, v1
v_xor_b32 v200, v5, v9
v_xor_b32 v201, 64, v200
v_xor_b32 v202, 128, v200
v_xor_b32 v203, 192, v200
s_lshr_b32 s45, s2, 3
s_lshl_b32 s40, s2, 20
s_mov_b32 s46, 0
s_mov_b32 s18, 1048576
s_mov_b32 s19, 0x20000
s_mul_i32 s50, s3, 20480
s_mov_b32 m0, s50
s_waitcnt lgkmcnt(0)
s_add_u32 s16, s6, s40
s_addc_u32 s17, s7, 0
s_and_b32 s17, s17, 0xffff
buffer_load_dwordx4 v200, s[16:19], s46 offen offset:0 nt lds
buffer_load_dwordx4 v201, s[16:19], s46 offen offset:1024 nt lds
buffer_load_dwordx4 v202, s[16:19], s46 offen offset:2048 nt lds
buffer_load_dwordx4 v203, s[16:19], s46 offen offset:3072 nt lds
v_lshrrev_b32 v2, 4, v1
v_and_b32 v3, 15, v1
v_and_b32 v7, 1, v1
v_lshl_add_u32 v208, v2, 1, v7
v_lshlrev_b32 v208, 4, v208
v_add_u32 v208, s50, v208
v_add_u32 v208, 0x4000, v208
v_lshlrev_b32 v7, 9, v7
v_lshl_add_u32 v7, v2, 4, v7
s_mov_b32 s26, 1024
s_mov_b32 s27, 0x20000
s_lshl_b32 s60, s45, 10
s_add_u32 s24, s4, s60
s_addc_u32 s25, s5, 0
s_and_b32 s25, s25, 0xffff
s_mov_b32 s52, s46
s_add_u32 s51, s50, 0x2000
s_add_u32 s47, s46, 0x1000
s_add_u32 s48, s46, 32768
s_add_u32 s49, s47, 32768
buffer_load_dwordx4 v[16:19], v7, s[24:27], 0 offen offset:0
buffer_load_dwordx4 v[20:23], v7, s[24:27], 0 offen offset:64
buffer_load_dwordx4 v[24:27], v7, s[24:27], 0 offen offset:128
buffer_load_dwordx4 v[28:31], v7, s[24:27], 0 offen offset:192
buffer_load_dwordx4 v[32:35], v7, s[24:27], 0 offen offset:256
buffer_load_dwordx4 v[36:39], v7, s[24:27], 0 offen offset:320
buffer_load_dwordx4 v[40:43], v7, s[24:27], 0 offen offset:384
buffer_load_dwordx4 v[44:47], v7, s[24:27], 0 offen offset:448
s_add_u32 m0, s50, 0x1000
s_nop 0
buffer_load_dwordx4 v200, s[16:19], s47 offen offset:0 nt lds
v_add_u32 v6, 0x1000, v5
v_bfe_u32 v4, v3, 2, 1
v_lshlrev_b32 v4, 3, v4
v_and_b32 v9, 3, v3
v_lshl_add_u32 v4, v9, 1, v4
v_lshrrev_b32 v9, 3, v3
v_add_u32 v4, v4, v9
v_and_b32 v9, 7, v4
v_lshlrev_b32 v9, 5, v9
v_lshlrev_b32 v204, 4, v2
v_xor_b32 v204, v204, v9
v_lshl_add_u32 v204, v4, 9, v204
v_xor_b32 v205, 64, v204
v_xor_b32 v206, 128, v204
v_xor_b32 v207, 192, v204
v_add_u32 v204, s50, v204
v_add_u32 v205, s50, v205
v_add_u32 v206, s50, v206
v_add_u32 v207, s50, v207
s_mov_b32 s42, 0x3db8aa3b
s_mov_b32 s43, 0x05040100
s_mov_b32 s44, 0x07060302
s_mov_b32 s58, 0x00030003
s_mov_b32 s59, 0x00030003
s_mov_b32 s22, 1048576
s_mov_b32 s23, 0x20000
s_add_u32 s20, s8, s40
s_addc_u32 s21, s9, 0
s_and_b32 s21, s21, 0xffff
s_mov_b32 s28, s14
s_and_b32 s29, s15, 0xffff
s_mov_b32 s30, 0x100000
s_mov_b32 s31, 0x20000
s_mov_b32 s32, s12
s_and_b32 s33, s13, 0xffff
s_mov_b32 s34, 256
s_mov_b32 s35, 0x20000
s_mov_b32 s36, s10
s_and_b32 s37, s11, 0xffff
s_mov_b32 s38, 32768
s_mov_b32 s39, 0x20000
v_mov_b32 v160, 0
v_mov_b32 v161, 0
v_mov_b32 v162, 0
v_mov_b32 v163, 0
v_mov_b32 v164, 0
v_mov_b32 v165, 0
v_mov_b32 v166, 0
v_mov_b32 v167, 0
v_mov_b32 v168, 0
v_mov_b32 v169, 0
v_mov_b32 v170, 0
v_mov_b32 v171, 0
v_mov_b32 v172, 0
v_mov_b32 v173, 0
v_mov_b32 v174, 0
v_mov_b32 v175, 0
v_mov_b32 v176, 0
v_mov_b32 v177, 0
v_mov_b32 v178, 0
v_mov_b32 v179, 0
v_mov_b32 v180, 0
v_mov_b32 v181, 0
v_mov_b32 v182, 0
v_mov_b32 v183, 0
v_mov_b32 v184, 0
v_mov_b32 v185, 0
v_mov_b32 v186, 0
v_mov_b32 v187, 0
v_mov_b32 v188, 0
v_mov_b32 v189, 0
v_mov_b32 v190, 0
v_mov_b32 v191, 0
v_mov_b32 v10, 0xff800000
v_mov_b32 v11, 0
s_mov_b32 s55, 0x2000
s_add_u32 m0, s50, 0x1000
s_waitcnt vmcnt(12)
buffer_load_dwordx4 v201, s[16:19], s47 offen offset:1024 nt lds
s_add_u32 m0, s50, 0x1000
s_waitcnt vmcnt(12)
buffer_load_dwordx4 v202, s[16:19], s47 offen offset:2048 nt lds
s_add_u32 m0, s50, 0x1000
s_waitcnt vmcnt(12)
buffer_load_dwordx4 v203, s[16:19], s47 offen offset:3072 nt lds
s_mov_b32 m0, s51
s_waitcnt vmcnt(12)
buffer_load_dwordx4 v200, s[16:19], s48 offen offset:0 nt lds
s_mov_b32 m0, s51
s_waitcnt vmcnt(4)
buffer_load_dwordx4 v201, s[16:19], s48 offen offset:1024 nt lds
s_mov_b32 m0, s51
s_waitcnt vmcnt(4)
buffer_load_dwordx4 v202, s[16:19], s48 offen offset:2048 nt lds
s_mov_b32 m0, s51
s_waitcnt vmcnt(4)
buffer_load_dwordx4 v203, s[16:19], s48 offen offset:3072 nt lds
s_add_u32 m0, s51, 0x1000
s_waitcnt vmcnt(4)
buffer_load_dwordx4 v200, s[16:19], s49 offen offset:0 nt lds
s_mov_b32 s46, s48
s_mov_b32 s47, s49
s_add_u32 s48, s48, 32768
s_add_u32 s49, s49, 32768
s_mov_b32 s54, s50
s_mov_b32 s50, s51
s_mov_b32 s51, s54
s_mov_b32 s41, 30
.p2align 6
L_kloop:
s_add_u32 m0, s50, 0x1000
s_waitcnt vmcnt(4)
buffer_load_dwordx4 v201, s[16:19], s47 offen offset:1024 nt lds
ds_read_b128 v[48:51], v204 offset:0
ds_read_b128 v[52:55], v205 offset:0
ds_read_b128 v[56:59], v206 offset:0
ds_read_b128 v[60:63], v207 offset:0
ds_read_b128 v[64:67], v204 offset:256
ds_read_b128 v[68:71], v205 offset:256
ds_read_b128 v[72:75], v206 offset:256
ds_read_b128 v[76:79], v207 offset:256
s_add_u32 m0, s50, 0x1000
s_waitcnt vmcnt(4)
buffer_load_dwordx4 v202, s[16:19], s47 offen offset:2048 nt lds
s_waitcnt lgkmcnt(7)
v_mfma_f32_16x16x32_bf16 v[192:195], v[48:51], v[16:19], 0
s_waitcnt lgkmcnt(6)
v_mfma_f32_16x16x32_bf16 v[192:195], v[52:55], v[20:23], v[192:195]
s_waitcnt lgkmcnt(5)
v_mfma_f32_16x16x32_bf16 v[192:195], v[56:59], v[24:27], v[192:195]
s_waitcnt lgkmcnt(4)
v_mfma_f32_16x16x32_bf16 v[192:195], v[60:63], v[28:31], v[192:195]
s_waitcnt lgkmcnt(3)
v_mfma_f32_16x16x32_bf16 v[192:195], v[64:67], v[32:35], v[192:195]
s_waitcnt lgkmcnt(2)
v_mfma_f32_16x16x32_bf16 v[192:195], v[68:71], v[36:39], v[192:195]
s_waitcnt lgkmcnt(1)
v_mfma_f32_16x16x32_bf16 v[192:195], v[72:75], v[40:43], v[192:195]
s_waitcnt lgkmcnt(0)
v_mfma_f32_16x16x32_bf16 v[192:195], v[76:79], v[44:47], v[192:195]
s_add_u32 m0, s50, 0x1000
s_waitcnt vmcnt(4)
buffer_load_dwordx4 v203, s[16:19], s47 offen offset:3072 nt lds
s_mov_b32 m0, s51
s_waitcnt vmcnt(4)
buffer_load_dwordx4 v200, s[16:19], s48 offen offset:0 nt lds
s_nop 3
v_max3_f32 v10, v192, v193, v10
v_max3_f32 v10, v194, v195, v10
s_mov_b64 exec, s[58:59]
ds_write_b128 v208, v[192:195]
s_mov_b64 exec, -1
v_add_u32 v208, 128, v208
v_add_u32 v204, s55, v204
v_add_u32 v205, s55, v205
v_add_u32 v206, s55, v206
v_add_u32 v207, s55, v207
s_sub_u32 s55, 0, s55
s_mov_b32 m0, s51
s_waitcnt vmcnt(4)
buffer_load_dwordx4 v201, s[16:19], s48 offen offset:1024 nt lds
s_mov_b32 m0, s51
s_waitcnt vmcnt(4)
buffer_load_dwordx4 v202, s[16:19], s48 offen offset:2048 nt lds
s_mov_b32 m0, s51
s_waitcnt vmcnt(4)
buffer_load_dwordx4 v203, s[16:19], s48 offen offset:3072 nt lds
s_add_u32 m0, s51, 0x1000
s_waitcnt vmcnt(4)
buffer_load_dwordx4 v200, s[16:19], s49 offen offset:0 nt lds
s_mov_b32 s46, s48
s_mov_b32 s47, s49
s_add_u32 s48, s48, 32768
s_add_u32 s49, s49, 32768
s_mov_b32 s54, s50
s_mov_b32 s50, s51
s_mov_b32 s51, s54
s_sub_u32 s41, s41, 1
s_cmp_lg_u32 s41, 0
s_cbranch_scc1 L_kloop
s_add_u32 m0, s50, 0x1000
s_waitcnt vmcnt(4)
buffer_load_dwordx4 v201, s[16:19], s47 offen offset:1024 nt lds
ds_read_b128 v[48:51], v204 offset:0
ds_read_b128 v[52:55], v205 offset:0
ds_read_b128 v[56:59], v206 offset:0
ds_read_b128 v[60:63], v207 offset:0
ds_read_b128 v[64:67], v204 offset:256
ds_read_b128 v[68:71], v205 offset:256
ds_read_b128 v[72:75], v206 offset:256
ds_read_b128 v[76:79], v207 offset:256
s_add_u32 m0, s50, 0x1000
s_waitcnt vmcnt(4)
buffer_load_dwordx4 v202, s[16:19], s47 offen offset:2048 nt lds
s_waitcnt lgkmcnt(7)
v_mfma_f32_16x16x32_bf16 v[192:195], v[48:51], v[16:19], 0
s_waitcnt lgkmcnt(6)
v_mfma_f32_16x16x32_bf16 v[192:195], v[52:55], v[20:23], v[192:195]
s_waitcnt lgkmcnt(5)
v_mfma_f32_16x16x32_bf16 v[192:195], v[56:59], v[24:27], v[192:195]
s_waitcnt lgkmcnt(4)
v_mfma_f32_16x16x32_bf16 v[192:195], v[60:63], v[28:31], v[192:195]
s_waitcnt lgkmcnt(3)
v_mfma_f32_16x16x32_bf16 v[192:195], v[64:67], v[32:35], v[192:195]
s_waitcnt lgkmcnt(2)
v_mfma_f32_16x16x32_bf16 v[192:195], v[68:71], v[36:39], v[192:195]
s_waitcnt lgkmcnt(1)
v_mfma_f32_16x16x32_bf16 v[192:195], v[72:75], v[40:43], v[192:195]
s_waitcnt lgkmcnt(0)
v_mfma_f32_16x16x32_bf16 v[192:195], v[76:79], v[44:47], v[192:195]
s_add_u32 m0, s50, 0x1000
s_waitcnt vmcnt(4)
buffer_load_dwordx4 v203, s[16:19], s47 offen offset:3072 nt lds
s_waitcnt vmcnt(4)
buffer_load_dwordx4 v[80:83], v5, s[20:23], s52 offen offset:0 nt
s_nop 3
v_max3_f32 v10, v192, v193, v10
v_max3_f32 v10, v194, v195, v10
s_mov_b64 exec, s[58:59]
ds_write_b128 v208, v[192:195]
s_mov_b64 exec, -1
v_add_u32 v208, 128, v208
v_add_u32 v204, s55, v204
v_add_u32 v205, s55, v205
v_add_u32 v206, s55, v206
v_add_u32 v207, s55, v207
s_sub_u32 s55, 0, s55
s_waitcnt vmcnt(4)
buffer_load_dwordx4 v[84:87], v5, s[20:23], s52 offen offset:1024 nt
s_waitcnt vmcnt(4)
buffer_load_dwordx4 v[88:91], v5, s[20:23], s52 offen offset:2048 nt
s_waitcnt vmcnt(4)
buffer_load_dwordx4 v[92:95], v5, s[20:23], s52 offen offset:3072 nt
s_waitcnt vmcnt(4)
buffer_load_dwordx4 v[96:99], v6, s[20:23], s52 offen offset:0 nt
s_mov_b32 s46, s52
s_add_u32 s48, s52, 32768
s_add_u32 s47, s48, 32768
s_waitcnt vmcnt(4)
buffer_load_dwordx4 v[100:103], v6, s[20:23], s46 offen offset:1024 nt
ds_read_b128 v[48:51], v204 offset:0
ds_read_b128 v[52:55], v205 offset:0
ds_read_b128 v[56:59], v206 offset:0
ds_read_b128 v[60:63], v207 offset:0
ds_read_b128 v[64:67], v204 offset:256
ds_read_b128 v[68:71], v205 offset:256
ds_read_b128 v[72:75], v206 offset:256
ds_read_b128 v[76:79], v207 offset:256
s_waitcnt vmcnt(4)
buffer_load_dwordx4 v[104:107], v6, s[20:23], s46 offen offset:2048 nt
s_waitcnt lgkmcnt(7)
v_mfma_f32_16x16x32_bf16 v[192:195], v[48:51], v[16:19], 0
s_waitcnt lgkmcnt(6)
v_mfma_f32_16x16x32_bf16 v[192:195], v[52:55], v[20:23], v[192:195]
s_waitcnt lgkmcnt(5)
v_mfma_f32_16x16x32_bf16 v[192:195], v[56:59], v[24:27], v[192:195]
s_waitcnt lgkmcnt(4)
v_mfma_f32_16x16x32_bf16 v[192:195], v[60:63], v[28:31], v[192:195]
s_waitcnt lgkmcnt(3)
v_mfma_f32_16x16x32_bf16 v[192:195], v[64:67], v[32:35], v[192:195]
s_waitcnt lgkmcnt(2)
v_mfma_f32_16x16x32_bf16 v[192:195], v[68:71], v[36:39], v[192:195]
s_waitcnt lgkmcnt(1)
v_mfma_f32_16x16x32_bf16 v[192:195], v[72:75], v[40:43], v[192:195]
s_waitcnt lgkmcnt(0)
v_mfma_f32_16x16x32_bf16 v[192:195], v[76:79], v[44:47], v[192:195]
v_perm_b32 v144, v84, v80, s43
v_perm_b32 v146, v84, v80, s44
v_perm_b32 v148, v85, v81, s43
v_perm_b32 v150, v85, v81, s44
v_perm_b32 v152, v86, v82, s43
v_perm_b32 v154, v86, v82, s44
v_perm_b32 v156, v87, v83, s43
v_perm_b32 v158, v87, v83, s44
s_waitcnt vmcnt(4)
buffer_load_dwordx4 v[108:111], v6, s[20:23], s46 offen offset:3072 nt
s_nop 5
v_max3_f32 v10, v192, v193, v10
v_max3_f32 v10, v194, v195, v10
s_mov_b64 exec, s[58:59]
ds_write_b128 v208, v[192:195]
s_mov_b64 exec, -1
v_add_u32 v208, 128, v208
v_add_u32 v204, s55, v204
v_add_u32 v205, s55, v205
v_add_u32 v206, s55, v206
v_add_u32 v207, s55, v207
s_sub_u32 s55, 0, s55
v_mov_b32 v9, v10
s_nop 1
v_permlane16_swap_b32 v10, v9
v_max_f32 v10, v10, v9
v_mov_b32 v9, v10
s_nop 1
v_permlane32_swap_b32 v10, v9
v_max_f32 v10, v10, v9
v_mul_f32 v10, s42, v10
v_subrev_u32 v208, 4096, v208
ds_read_b128 v[192:195], v208
v_add_u32 v208, 128, v208
s_waitcnt vmcnt(4)
buffer_load_dwordx4 v[112:115], v5, s[20:23], s48 offen offset:0 nt
v_perm_b32 v145, v92, v88, s43
v_perm_b32 v147, v92, v88, s44
v_perm_b32 v149, v93, v89, s43
v_perm_b32 v151, v93, v89, s44
v_perm_b32 v153, v94, v90, s43
v_perm_b32 v155, v94, v90, s44
v_perm_b32 v157, v95, v91, s43
v_perm_b32 v159, v95, v91, s44
s_waitcnt lgkmcnt(0)
v_fma_f32 v196, v192, s42, -v10
v_fma_f32 v197, v193, s42, -v10
v_fma_f32 v198, v194, s42, -v10
v_fma_f32 v199, v195, s42, -v10
v_exp_f32 v196, v196
v_exp_f32 v197, v197
v_exp_f32 v198, v198
v_exp_f32 v199, v199
s_nop 0
v_cvt_pk_bf16_f32 v12, v196, v197
v_cvt_pk_bf16_f32 v13, v198, v199
v_mov_b32 v14, v12
v_mov_b32 v15, v13
v_add_f32 v8, v196, v197
v_add_f32 v9, v198, v199
v_permlane16_swap_b32 v12, v14
v_permlane16_swap_b32 v13, v15
v_add_f32 v8, v8, v9
v_add_f32 v11, v11, v8
s_nop 1
v_mfma_f32_4x4x4_16b_bf16 v[160:163], v[12:13], v[144:145], v[160:163]
v_mfma_f32_4x4x4_16b_bf16 v[164:167], v[12:13], v[146:147], v[164:167]
v_mfma_f32_4x4x4_16b_bf16 v[168:171], v[12:13], v[148:149], v[168:171]
v_mfma_f32_4x4x4_16b_bf16 v[172:175], v[12:13], v[150:151], v[172:175]
v_mfma_f32_4x4x4_16b_bf16 v[176:179], v[12:13], v[152:153], v[176:179]
v_mfma_f32_4x4x4_16b_bf16 v[180:183], v[12:13], v[154:155], v[180:183]
v_mfma_f32_4x4x4_16b_bf16 v[184:187], v[12:13], v[156:157], v[184:187]
v_mfma_f32_4x4x4_16b_bf16 v[188:191], v[12:13], v[158:159], v[188:191]
s_waitcnt vmcnt(4)
buffer_load_dwordx4 v[116:119], v5, s[20:23], s48 offen offset:1024 nt
s_waitcnt vmcnt(4)
buffer_load_dwordx4 v[120:123], v5, s[20:23], s48 offen offset:2048 nt
v_perm_b32 v144, v100, v96, s43
v_perm_b32 v146, v100, v96, s44
v_perm_b32 v148, v101, v97, s43
v_perm_b32 v150, v101, v97, s44
v_perm_b32 v152, v102, v98, s43
v_perm_b32 v154, v102, v98, s44
v_perm_b32 v156, v103, v99, s43
v_perm_b32 v158, v103, v99, s44
s_waitcnt vmcnt(4)
buffer_load_dwordx4 v[124:127], v5, s[20:23], s48 offen offset:3072 nt
s_waitcnt vmcnt(4)
buffer_load_dwordx4 v[128:131], v6, s[20:23], s48 offen offset:0 nt
v_perm_b32 v145, v108, v104, s43
v_perm_b32 v147, v108, v104, s44
v_perm_b32 v149, v109, v105, s43
v_perm_b32 v151, v109, v105, s44
v_perm_b32 v153, v110, v106, s43
v_perm_b32 v155, v110, v106, s44
v_perm_b32 v157, v111, v107, s43
v_perm_b32 v159, v111, v107, s44
s_nop 1
v_mfma_f32_4x4x4_16b_bf16 v[160:163], v[14:15], v[144:145], v[160:163]
v_mfma_f32_4x4x4_16b_bf16 v[164:167], v[14:15], v[146:147], v[164:167]
v_mfma_f32_4x4x4_16b_bf16 v[168:171], v[14:15], v[148:149], v[168:171]
v_mfma_f32_4x4x4_16b_bf16 v[172:175], v[14:15], v[150:151], v[172:175]
v_mfma_f32_4x4x4_16b_bf16 v[176:179], v[14:15], v[152:153], v[176:179]
v_mfma_f32_4x4x4_16b_bf16 v[180:183], v[14:15], v[154:155], v[180:183]
v_mfma_f32_4x4x4_16b_bf16 v[184:187], v[14:15], v[156:157], v[184:187]
v_mfma_f32_4x4x4_16b_bf16 v[188:191], v[14:15], v[158:159], v[188:191]
s_mov_b32 s46, s48
s_mov_b32 s48, s47
s_add_u32 s47, s47, 32768
s_mov_b32 s41, 8
.p2align 6
L_vloop:
s_waitcnt vmcnt(4)
buffer_load_dwordx4 v[132:135], v6, s[20:23], s46 offen offset:1024 nt
ds_read_b128 v[192:195], v208
v_add_u32 v208, 128, v208
s_waitcnt vmcnt(4)
buffer_load_dwordx4 v[136:139], v6, s[20:23], s46 offen offset:2048 nt
v_perm_b32 v144, v116, v112, s43
v_perm_b32 v146, v116, v112, s44
v_perm_b32 v148, v117, v113, s43
v_perm_b32 v150, v117, v113, s44
v_perm_b32 v152, v118, v114, s43
v_perm_b32 v154, v118, v114, s44
v_perm_b32 v156, v119, v115, s43
v_perm_b32 v158, v119, v115, s44
s_waitcnt vmcnt(4)
buffer_load_dwordx4 v[140:143], v6, s[20:23], s46 offen offset:3072 nt
s_waitcnt lgkmcnt(0)
v_fma_f32 v196, v192, s42, -v10
v_fma_f32 v197, v193, s42, -v10
v_fma_f32 v198, v194, s42, -v10
v_fma_f32 v199, v195, s42, -v10
v_exp_f32 v196, v196
v_exp_f32 v197, v197
v_exp_f32 v198, v198
v_exp_f32 v199, v199
s_nop 0
v_cvt_pk_bf16_f32 v12, v196, v197
v_cvt_pk_bf16_f32 v13, v198, v199
v_mov_b32 v14, v12
v_mov_b32 v15, v13
v_add_f32 v8, v196, v197
v_add_f32 v9, v198, v199
v_permlane16_swap_b32 v12, v14
v_permlane16_swap_b32 v13, v15
v_add_f32 v8, v8, v9
v_add_f32 v11, v11, v8
s_waitcnt vmcnt(4)
buffer_load_dwordx4 v[80:83], v5, s[20:23], s48 offen offset:0 nt
v_perm_b32 v145, v124, v120, s43
v_perm_b32 v147, v124, v120, s44
v_perm_b32 v149, v125, v121, s43
v_perm_b32 v151, v125, v121, s44
v_perm_b32 v153, v126, v122, s43
v_perm_b32 v155, v126, v122, s44
v_perm_b32 v157, v127, v123, s43
v_perm_b32 v159, v127, v123, s44
s_nop 1
v_mfma_f32_4x4x4_16b_bf16 v[160:163], v[12:13], v[144:145], v[160:163]
v_mfma_f32_4x4x4_16b_bf16 v[164:167], v[12:13], v[146:147], v[164:167]
v_mfma_f32_4x4x4_16b_bf16 v[168:171], v[12:13], v[148:149], v[168:171]
v_mfma_f32_4x4x4_16b_bf16 v[172:175], v[12:13], v[150:151], v[172:175]
v_mfma_f32_4x4x4_16b_bf16 v[176:179], v[12:13], v[152:153], v[176:179]
v_mfma_f32_4x4x4_16b_bf16 v[180:183], v[12:13], v[154:155], v[180:183]
v_mfma_f32_4x4x4_16b_bf16 v[184:187], v[12:13], v[156:157], v[184:187]
v_mfma_f32_4x4x4_16b_bf16 v[188:191], v[12:13], v[158:159], v[188:191]
s_waitcnt vmcnt(4)
buffer_load_dwordx4 v[84:87], v5, s[20:23], s48 offen offset:1024 nt
s_waitcnt vmcnt(4)
buffer_load_dwordx4 v[88:91], v5, s[20:23], s48 offen offset:2048 nt
v_perm_b32 v144, v132, v128, s43
v_perm_b32 v146, v132, v128, s44
v_perm_b32 v148, v133, v129, s43
v_perm_b32 v150, v133, v129, s44
v_perm_b32 v152, v134, v130, s43
v_perm_b32 v154, v134, v130, s44
v_perm_b32 v156, v135, v131, s43
v_perm_b32 v158, v135, v131, s44
s_waitcnt vmcnt(4)
buffer_load_dwordx4 v[92:95], v5, s[20:23], s48 offen offset:3072 nt
s_waitcnt vmcnt(4)
buffer_load_dwordx4 v[96:99], v6, s[20:23], s48 offen offset:0 nt
v_perm_b32 v145, v140, v136, s43
v_perm_b32 v147, v140, v136, s44
v_perm_b32 v149, v141, v137, s43
v_perm_b32 v151, v141, v137, s44
v_perm_b32 v153, v142, v138, s43
v_perm_b32 v155, v142, v138, s44
v_perm_b32 v157, v143, v139, s43
v_perm_b32 v159, v143, v139, s44
s_nop 1
v_mfma_f32_4x4x4_16b_bf16 v[160:163], v[14:15], v[144:145], v[160:163]
v_mfma_f32_4x4x4_16b_bf16 v[164:167], v[14:15], v[146:147], v[164:167]
v_mfma_f32_4x4x4_16b_bf16 v[168:171], v[14:15], v[148:149], v[168:171]
v_mfma_f32_4x4x4_16b_bf16 v[172:175], v[14:15], v[150:151], v[172:175]
v_mfma_f32_4x4x4_16b_bf16 v[176:179], v[14:15], v[152:153], v[176:179]
v_mfma_f32_4x4x4_16b_bf16 v[180:183], v[14:15], v[154:155], v[180:183]
v_mfma_f32_4x4x4_16b_bf16 v[184:187], v[14:15], v[156:157], v[184:187]
v_mfma_f32_4x4x4_16b_bf16 v[188:191], v[14:15], v[158:159], v[188:191]
s_mov_b32 s46, s48
s_mov_b32 s48, s47
s_add_u32 s47, s47, 32768
s_waitcnt vmcnt(4)
buffer_load_dwordx4 v[100:103], v6, s[20:23], s46 offen offset:1024 nt
ds_read_b128 v[192:195], v208
v_add_u32 v208, 128, v208
s_waitcnt vmcnt(4)
buffer_load_dwordx4 v[104:107], v6, s[20:23], s46 offen offset:2048 nt
v_perm_b32 v144, v84, v80, s43
v_perm_b32 v146, v84, v80, s44
v_perm_b32 v148, v85, v81, s43
v_perm_b32 v150, v85, v81, s44
v_perm_b32 v152, v86, v82, s43
v_perm_b32 v154, v86, v82, s44
v_perm_b32 v156, v87, v83, s43
v_perm_b32 v158, v87, v83, s44
s_waitcnt vmcnt(4)
buffer_load_dwordx4 v[108:111], v6, s[20:23], s46 offen offset:3072 nt
s_waitcnt lgkmcnt(0)
v_fma_f32 v196, v192, s42, -v10
v_fma_f32 v197, v193, s42, -v10
v_fma_f32 v198, v194, s42, -v10
v_fma_f32 v199, v195, s42, -v10
v_exp_f32 v196, v196
v_exp_f32 v197, v197
v_exp_f32 v198, v198
v_exp_f32 v199, v199
s_nop 0
v_cvt_pk_bf16_f32 v12, v196, v197
v_cvt_pk_bf16_f32 v13, v198, v199
v_mov_b32 v14, v12
v_mov_b32 v15, v13
v_add_f32 v8, v196, v197
v_add_f32 v9, v198, v199
v_permlane16_swap_b32 v12, v14
v_permlane16_swap_b32 v13, v15
v_add_f32 v8, v8, v9
v_add_f32 v11, v11, v8
s_waitcnt vmcnt(4)
buffer_load_dwordx4 v[112:115], v5, s[20:23], s48 offen offset:0 nt
v_perm_b32 v145, v92, v88, s43
v_perm_b32 v147, v92, v88, s44
v_perm_b32 v149, v93, v89, s43
v_perm_b32 v151, v93, v89, s44
v_perm_b32 v153, v94, v90, s43
v_perm_b32 v155, v94, v90, s44
v_perm_b32 v157, v95, v91, s43
v_perm_b32 v159, v95, v91, s44
s_nop 1
v_mfma_f32_4x4x4_16b_bf16 v[160:163], v[12:13], v[144:145], v[160:163]
v_mfma_f32_4x4x4_16b_bf16 v[164:167], v[12:13], v[146:147], v[164:167]
v_mfma_f32_4x4x4_16b_bf16 v[168:171], v[12:13], v[148:149], v[168:171]
v_mfma_f32_4x4x4_16b_bf16 v[172:175], v[12:13], v[150:151], v[172:175]
v_mfma_f32_4x4x4_16b_bf16 v[176:179], v[12:13], v[152:153], v[176:179]
v_mfma_f32_4x4x4_16b_bf16 v[180:183], v[12:13], v[154:155], v[180:183]
v_mfma_f32_4x4x4_16b_bf16 v[184:187], v[12:13], v[156:157], v[184:187]
v_mfma_f32_4x4x4_16b_bf16 v[188:191], v[12:13], v[158:159], v[188:191]
s_waitcnt vmcnt(4)
buffer_load_dwordx4 v[116:119], v5, s[20:23], s48 offen offset:1024 nt
s_waitcnt vmcnt(4)
buffer_load_dwordx4 v[120:123], v5, s[20:23], s48 offen offset:2048 nt
v_perm_b32 v144, v100, v96, s43
v_perm_b32 v146, v100, v96, s44
v_perm_b32 v148, v101, v97, s43
v_perm_b32 v150, v101, v97, s44
v_perm_b32 v152, v102, v98, s43
v_perm_b32 v154, v102, v98, s44
v_perm_b32 v156, v103, v99, s43
v_perm_b32 v158, v103, v99, s44
s_waitcnt vmcnt(4)
buffer_load_dwordx4 v[124:127], v5, s[20:23], s48 offen offset:3072 nt
s_waitcnt vmcnt(4)
buffer_load_dwordx4 v[128:131], v6, s[20:23], s48 offen offset:0 nt
v_perm_b32 v145, v108, v104, s43
v_perm_b32 v147, v108, v104, s44
v_perm_b32 v149, v109, v105, s43
v_perm_b32 v151, v109, v105, s44
v_perm_b32 v153, v110, v106, s43
v_perm_b32 v155, v110, v106, s44
v_perm_b32 v157, v111, v107, s43
v_perm_b32 v159, v111, v107, s44
s_nop 1
v_mfma_f32_4x4x4_16b_bf16 v[160:163], v[14:15], v[144:145], v[160:163]
v_mfma_f32_4x4x4_16b_bf16 v[164:167], v[14:15], v[146:147], v[164:167]
v_mfma_f32_4x4x4_16b_bf16 v[168:171], v[14:15], v[148:149], v[168:171]
v_mfma_f32_4x4x4_16b_bf16 v[172:175], v[14:15], v[150:151], v[172:175]
v_mfma_f32_4x4x4_16b_bf16 v[176:179], v[14:15], v[152:153], v[176:179]
v_mfma_f32_4x4x4_16b_bf16 v[180:183], v[14:15], v[154:155], v[180:183]
v_mfma_f32_4x4x4_16b_bf16 v[184:187], v[14:15], v[156:157], v[184:187]
v_mfma_f32_4x4x4_16b_bf16 v[188:191], v[14:15], v[158:159], v[188:191]
s_mov_b32 s46, s48
s_mov_b32 s48, s47
s_add_u32 s47, s47, 32768
s_sub_u32 s41, s41, 1
s_cmp_lg_u32 s41, 0
s_cbranch_scc1 L_vloop
buffer_load_dwordx4 v[132:135], v6, s[20:23], s46 offen offset:1024 nt
buffer_load_dwordx4 v[136:139], v6, s[20:23], s46 offen offset:2048 nt
buffer_load_dwordx4 v[140:143], v6, s[20:23], s46 offen offset:3072 nt
buffer_load_dwordx4 v[80:83], v5, s[20:23], s48 offen offset:0 nt
buffer_load_dwordx4 v[84:87], v5, s[20:23], s48 offen offset:1024 nt
s_mov_b32 s41, 7
.p2align 6
L_vloop2:
s_waitcnt vmcnt(9)
buffer_load_dwordx4 v[88:91], v5, s[20:23], s48 offen offset:2048 nt
ds_read_b128 v[192:195], v208
v_add_u32 v208, 128, v208
s_waitcnt vmcnt(9)
buffer_load_dwordx4 v[92:95], v5, s[20:23], s48 offen offset:3072 nt
v_perm_b32 v144, v116, v112, s43
v_perm_b32 v146, v116, v112, s44
v_perm_b32 v148, v117, v113, s43
v_perm_b32 v150, v117, v113, s44
v_perm_b32 v152, v118, v114, s43
v_perm_b32 v154, v118, v114, s44
v_perm_b32 v156, v119, v115, s43
v_perm_b32 v158, v119, v115, s44
s_waitcnt vmcnt(9)
buffer_load_dwordx4 v[96:99], v6, s[20:23], s48 offen offset:0 nt
s_waitcnt lgkmcnt(0)
v_fma_f32 v196, v192, s42, -v10
v_fma_f32 v197, v193, s42, -v10
v_fma_f32 v198, v194, s42, -v10
v_fma_f32 v199, v195, s42, -v10
v_exp_f32 v196, v196
v_exp_f32 v197, v197
v_exp_f32 v198, v198
v_exp_f32 v199, v199
s_nop 0
v_cvt_pk_bf16_f32 v12, v196, v197
v_cvt_pk_bf16_f32 v13, v198, v199
v_mov_b32 v14, v12
v_mov_b32 v15, v13
v_add_f32 v8, v196, v197
v_add_f32 v9, v198, v199
v_permlane16_swap_b32 v12, v14
v_permlane16_swap_b32 v13, v15
v_add_f32 v8, v8, v9
v_add_f32 v11, v11, v8
s_waitcnt vmcnt(9)
buffer_load_dwordx4 v[100:103], v6, s[20:23], s48 offen offset:1024 nt
v_perm_b32 v145, v124, v120, s43
v_perm_b32 v147, v124, v120, s44
v_perm_b32 v149, v125, v121, s43
v_perm_b32 v151, v125, v121, s44
v_perm_b32 v153, v126, v122, s43
v_perm_b32 v155, v126, v122, s44
v_perm_b32 v157, v127, v123, s43
v_perm_b32 v159, v127, v123, s44
s_nop 1
v_mfma_f32_4x4x4_16b_bf16 v[160:163], v[12:13], v[144:145], v[160:163]
v_mfma_f32_4x4x4_16b_bf16 v[164:167], v[12:13], v[146:147], v[164:167]
v_mfma_f32_4x4x4_16b_bf16 v[168:171], v[12:13], v[148:149], v[168:171]
v_mfma_f32_4x4x4_16b_bf16 v[172:175], v[12:13], v[150:151], v[172:175]
v_mfma_f32_4x4x4_16b_bf16 v[176:179], v[12:13], v[152:153], v[176:179]
v_mfma_f32_4x4x4_16b_bf16 v[180:183], v[12:13], v[154:155], v[180:183]
v_mfma_f32_4x4x4_16b_bf16 v[184:187], v[12:13], v[156:157], v[184:187]
v_mfma_f32_4x4x4_16b_bf16 v[188:191], v[12:13], v[158:159], v[188:191]
s_waitcnt vmcnt(9)
buffer_load_dwordx4 v[104:107], v6, s[20:23], s48 offen offset:2048 nt
s_waitcnt vmcnt(9)
buffer_load_dwordx4 v[108:111], v6, s[20:23], s48 offen offset:3072 nt
v_perm_b32 v144, v132, v128, s43
v_perm_b32 v146, v132, v128, s44
v_perm_b32 v148, v133, v129, s43
v_perm_b32 v150, v133, v129, s44
v_perm_b32 v152, v134, v130, s43
v_perm_b32 v154, v134, v130, s44
v_perm_b32 v156, v135, v131, s43
v_perm_b32 v158, v135, v131, s44
s_waitcnt vmcnt(9)
buffer_load_dwordx4 v[112:115], v5, s[20:23], s47 offen offset:0 nt
s_waitcnt vmcnt(9)
buffer_load_dwordx4 v[116:119], v5, s[20:23], s47 offen offset:1024 nt
v_perm_b32 v145, v140, v136, s43
v_perm_b32 v147, v140, v136, s44
v_perm_b32 v149, v141, v137, s43
v_perm_b32 v151, v141, v137, s44
v_perm_b32 v153, v142, v138, s43
v_perm_b32 v155, v142, v138, s44
v_perm_b32 v157, v143, v139, s43
v_perm_b32 v159, v143, v139, s44
s_nop 1
v_mfma_f32_4x4x4_16b_bf16 v[160:163], v[14:15], v[144:145], v[160:163]
v_mfma_f32_4x4x4_16b_bf16 v[164:167], v[14:15], v[146:147], v[164:167]
v_mfma_f32_4x4x4_16b_bf16 v[168:171], v[14:15], v[148:149], v[168:171]
v_mfma_f32_4x4x4_16b_bf16 v[172:175], v[14:15], v[150:151], v[172:175]
v_mfma_f32_4x4x4_16b_bf16 v[176:179], v[14:15], v[152:153], v[176:179]
v_mfma_f32_4x4x4_16b_bf16 v[180:183], v[14:15], v[154:155], v[180:183]
v_mfma_f32_4x4x4_16b_bf16 v[184:187], v[14:15], v[156:157], v[184:187]
v_mfma_f32_4x4x4_16b_bf16 v[188:191], v[14:15], v[158:159], v[188:191]
s_mov_b32 s46, s48
s_mov_b32 s48, s47
s_add_u32 s47, s47, 32768
s_waitcnt vmcnt(9)
buffer_load_dwordx4 v[120:123], v5, s[20:23], s48 offen offset:2048 nt
ds_read_b128 v[192:195], v208
v_add_u32 v208, 128, v208
s_waitcnt vmcnt(9)
buffer_load_dwordx4 v[124:127], v5, s[20:23], s48 offen offset:3072 nt
v_perm_b32 v144, v84, v80, s43
v_perm_b32 v146, v84, v80, s44
v_perm_b32 v148, v85, v81, s43
v_perm_b32 v150, v85, v81, s44
v_perm_b32 v152, v86, v82, s43
v_perm_b32 v154, v86, v82, s44
v_perm_b32 v156, v87, v83, s43
v_perm_b32 v158, v87, v83, s44
s_waitcnt vmcnt(9)
buffer_load_dwordx4 v[128:131], v6, s[20:23], s48 offen offset:0 nt
s_waitcnt lgkmcnt(0)
v_fma_f32 v196, v192, s42, -v10
v_fma_f32 v197, v193, s42, -v10
v_fma_f32 v198, v194, s42, -v10
v_fma_f32 v199, v195, s42, -v10
v_exp_f32 v196, v196
v_exp_f32 v197, v197
v_exp_f32 v198, v198
v_exp_f32 v199, v199
s_nop 0
v_cvt_pk_bf16_f32 v12, v196, v197
v_cvt_pk_bf16_f32 v13, v198, v199
v_mov_b32 v14, v12
v_mov_b32 v15, v13
v_add_f32 v8, v196, v197
v_add_f32 v9, v198, v199
v_permlane16_swap_b32 v12, v14
v_permlane16_swap_b32 v13, v15
v_add_f32 v8, v8, v9
v_add_f32 v11, v11, v8
s_waitcnt vmcnt(9)
buffer_load_dwordx4 v[132:135], v6, s[20:23], s48 offen offset:1024 nt
v_perm_b32 v145, v92, v88, s43
v_perm_b32 v147, v92, v88, s44
v_perm_b32 v149, v93, v89, s43
v_perm_b32 v151, v93, v89, s44
v_perm_b32 v153, v94, v90, s43
v_perm_b32 v155, v94, v90, s44
v_perm_b32 v157, v95, v91, s43
v_perm_b32 v159, v95, v91, s44
s_nop 1
v_mfma_f32_4x4x4_16b_bf16 v[160:163], v[12:13], v[144:145], v[160:163]
v_mfma_f32_4x4x4_16b_bf16 v[164:167], v[12:13], v[146:147], v[164:167]
v_mfma_f32_4x4x4_16b_bf16 v[168:171], v[12:13], v[148:149], v[168:171]
v_mfma_f32_4x4x4_16b_bf16 v[172:175], v[12:13], v[150:151], v[172:175]
v_mfma_f32_4x4x4_16b_bf16 v[176:179], v[12:13], v[152:153], v[176:179]
v_mfma_f32_4x4x4_16b_bf16 v[180:183], v[12:13], v[154:155], v[180:183]
v_mfma_f32_4x4x4_16b_bf16 v[184:187], v[12:13], v[156:157], v[184:187]
v_mfma_f32_4x4x4_16b_bf16 v[188:191], v[12:13], v[158:159], v[188:191]
s_waitcnt vmcnt(9)
buffer_load_dwordx4 v[136:139], v6, s[20:23], s48 offen offset:2048 nt
s_waitcnt vmcnt(9)
buffer_load_dwordx4 v[140:143], v6, s[20:23], s48 offen offset:3072 nt
v_perm_b32 v144, v100, v96, s43
v_perm_b32 v146, v100, v96, s44
v_perm_b32 v148, v101, v97, s43
v_perm_b32 v150, v101, v97, s44
v_perm_b32 v152, v102, v98, s43
v_perm_b32 v154, v102, v98, s44
v_perm_b32 v156, v103, v99, s43
v_perm_b32 v158, v103, v99, s44
s_waitcnt vmcnt(9)
buffer_load_dwordx4 v[80:83], v5, s[20:23], s47 offen offset:0 nt
s_waitcnt vmcnt(9)
buffer_load_dwordx4 v[84:87], v5, s[20:23], s47 offen offset:1024 nt
v_perm_b32 v145, v108, v104, s43
v_perm_b32 v147, v108, v104, s44
v_perm_b32 v149, v109, v105, s43
v_perm_b32 v151, v109, v105, s44
v_perm_b32 v153, v110, v106, s43
v_perm_b32 v155, v110, v106, s44
v_perm_b32 v157, v111, v107, s43
v_perm_b32 v159, v111, v107, s44
s_nop 1
v_mfma_f32_4x4x4_16b_bf16 v[160:163], v[14:15], v[144:145], v[160:163]
v_mfma_f32_4x4x4_16b_bf16 v[164:167], v[14:15], v[146:147], v[164:167]
v_mfma_f32_4x4x4_16b_bf16 v[168:171], v[14:15], v[148:149], v[168:171]
v_mfma_f32_4x4x4_16b_bf16 v[172:175], v[14:15], v[150:151], v[172:175]
v_mfma_f32_4x4x4_16b_bf16 v[176:179], v[14:15], v[152:153], v[176:179]
v_mfma_f32_4x4x4_16b_bf16 v[180:183], v[14:15], v[154:155], v[180:183]
v_mfma_f32_4x4x4_16b_bf16 v[184:187], v[14:15], v[156:157], v[184:187]
v_mfma_f32_4x4x4_16b_bf16 v[188:191], v[14:15], v[158:159], v[188:191]
s_mov_b32 s46, s48
s_mov_b32 s48, s47
s_add_u32 s47, s47, 32768
s_sub_u32 s41, s41, 1
s_cmp_lg_u32 s41, 0
s_cbranch_scc1 L_vloop2
s_waitcnt vmcnt(9)
ds_read_b128 v[192:195], v208
v_add_u32 v208, 128, v208
s_waitcnt vmcnt(8)
v_perm_b32 v144, v116, v112, s43
v_perm_b32 v146, v116, v112, s44
v_perm_b32 v148, v117, v113, s43
v_perm_b32 v150, v117, v113, s44
v_perm_b32 v152, v118, v114, s43
v_perm_b32 v154, v118, v114, s44
v_perm_b32 v156, v119, v115, s43
v_perm_b32 v158, v119, v115, s44
s_waitcnt vmcnt(7)
s_waitcnt lgkmcnt(0)
v_fma_f32 v196, v192, s42, -v10
v_fma_f32 v197, v193, s42, -v10
v_fma_f32 v198, v194, s42, -v10
v_fma_f32 v199, v195, s42, -v10
v_exp_f32 v196, v196
v_exp_f32 v197, v197
v_exp_f32 v198, v198
v_exp_f32 v199, v199
s_nop 0
v_cvt_pk_bf16_f32 v12, v196, v197
v_cvt_pk_bf16_f32 v13, v198, v199
v_mov_b32 v14, v12
v_mov_b32 v15, v13
v_add_f32 v8, v196, v197
v_add_f32 v9, v198, v199
v_permlane16_swap_b32 v12, v14
v_permlane16_swap_b32 v13, v15
v_add_f32 v8, v8, v9
v_add_f32 v11, v11, v8
s_waitcnt vmcnt(6)
v_perm_b32 v145, v124, v120, s43
v_perm_b32 v147, v124, v120, s44
v_perm_b32 v149, v125, v121, s43
v_perm_b32 v151, v125, v121, s44
v_perm_b32 v153, v126, v122, s43
v_perm_b32 v155, v126, v122, s44
v_perm_b32 v157, v127, v123, s43
v_perm_b32 v159, v127, v123, s44
s_nop 1
v_mfma_f32_4x4x4_16b_bf16 v[160:163], v[12:13], v[144:145], v[160:163]
v_mfma_f32_4x4x4_16b_bf16 v[164:167], v[12:13], v[146:147], v[164:167]
v_mfma_f32_4x4x4_16b_bf16 v[168:171], v[12:13], v[148:149], v[168:171]
v_mfma_f32_4x4x4_16b_bf16 v[172:175], v[12:13], v[150:151], v[172:175]
v_mfma_f32_4x4x4_16b_bf16 v[176:179], v[12:13], v[152:153], v[176:179]
v_mfma_f32_4x4x4_16b_bf16 v[180:183], v[12:13], v[154:155], v[180:183]
v_mfma_f32_4x4x4_16b_bf16 v[184:187], v[12:13], v[156:157], v[184:187]
v_mfma_f32_4x4x4_16b_bf16 v[188:191], v[12:13], v[158:159], v[188:191]
s_waitcnt vmcnt(5)
v_mov_b32 v9, v11
s_nop 1
v_permlane16_swap_b32 v11, v9
v_add_f32 v11, v11, v9
v_mov_b32 v9, v11
s_nop 1
v_permlane32_swap_b32 v11, v9
v_add_f32 v11, v11, v9
v_lshlrev_b32 v202, 5, v1
v_add_u32 v202, 81920, v202
s_lshl_b32 s60, s3, 11
v_add_u32 v200, s60, v202
s_lshl_b32 s60, s3, 3
v_add_u32 v201, s60, v202
s_mov_b64 exec, 3
ds_write_b64 v201, v[10:11] offset:8192
s_mov_b64 exec, -1
v_and_b32 v203, 32, v1
v_add_u32 v203, 81920, v203
v_lshlrev_b32 v7, 4, v1
s_lshl_b32 s60, s45, 15
s_and_b32 s61, s2, 7
s_lshl_b32 s61, s61, 12
s_add_u32 s61, s61, s60
s_lshl_b32 s65, s45, 3
v_mov_b32 v204, 1
v_mov_b32 v205, s65
s_waitcnt vmcnt(4)
v_perm_b32 v144, v132, v128, s43
v_perm_b32 v146, v132, v128, s44
v_perm_b32 v148, v133, v129, s43
v_perm_b32 v150, v133, v129, s44
v_perm_b32 v152, v134, v130, s43
v_perm_b32 v154, v134, v130, s44
v_perm_b32 v156, v135, v131, s43
v_perm_b32 v158, v135, v131, s44
s_waitcnt vmcnt(3)
s_waitcnt vmcnt(2)
v_perm_b32 v145, v140, v136, s43
v_perm_b32 v147, v140, v136, s44
v_perm_b32 v149, v141, v137, s43
v_perm_b32 v151, v141, v137, s44
v_perm_b32 v153, v142, v138, s43
v_perm_b32 v155, v142, v138, s44
v_perm_b32 v157, v143, v139, s43
v_perm_b32 v159, v143, v139, s44
s_nop 1
v_mfma_f32_4x4x4_16b_bf16 v[160:163], v[14:15], v[144:145], v[160:163]
v_mfma_f32_4x4x4_16b_bf16 v[164:167], v[14:15], v[146:147], v[164:167]
v_mfma_f32_4x4x4_16b_bf16 v[168:171], v[14:15], v[148:149], v[168:171]
v_mfma_f32_4x4x4_16b_bf16 v[172:175], v[14:15], v[150:151], v[172:175]
v_mfma_f32_4x4x4_16b_bf16 v[176:179], v[14:15], v[152:153], v[176:179]
v_mfma_f32_4x4x4_16b_bf16 v[180:183], v[14:15], v[154:155], v[180:183]
v_mfma_f32_4x4x4_16b_bf16 v[184:187], v[14:15], v[156:157], v[184:187]
v_mfma_f32_4x4x4_16b_bf16 v[188:191], v[14:15], v[158:159], v[188:191]
s_nop 4
v_permlane32_swap_b32 v160, v161
v_permlane32_swap_b32 v164, v165
v_permlane32_swap_b32 v168, v169
v_permlane32_swap_b32 v172, v173
v_permlane32_swap_b32 v176, v177
v_permlane32_swap_b32 v180, v181
v_permlane32_swap_b32 v184, v185
v_permlane32_swap_b32 v188, v189
v_add_f32 v48, v160, v161
v_add_f32 v49, v164, v165
v_add_f32 v50, v168, v169
v_add_f32 v51, v172, v173
v_add_f32 v52, v176, v177
v_add_f32 v53, v180, v181
v_add_f32 v54, v184, v185
v_add_f32 v55, v188, v189
ds_write_b128 v200, v[48:51]
ds_write_b128 v200, v[52:55] offset:16
s_waitcnt lgkmcnt(0)
s_barrier
s_mov_b32 s64, 0
s_cmp_lg_u32 s3, 0
s_cbranch_scc1 L_end
ds_read_b128 v[16:19], v203 offset:8192
ds_read_b128 v[20:23], v203 offset:8208
ds_read_b128 v[48:51], v202 offset:0
ds_read_b128 v[52:55], v202 offset:16
ds_read_b128 v[56:59], v202 offset:2048
ds_read_b128 v[60:63], v202 offset:2064
ds_read_b128 v[64:67], v202 offset:4096
ds_read_b128 v[68:71], v202 offset:4112
ds_read_b128 v[72:75], v202 offset:6144
ds_read_b128 v[76:79], v202 offset:6160
s_waitcnt lgkmcnt(8)
v_max3_f32 v168, v16, v18, v20
v_max_f32 v168, v168, v22
v_sub_f32 v24, v16, v168
v_sub_f32 v25, v18, v168
v_sub_f32 v26, v20, v168
v_sub_f32 v27, v22, v168
v_exp_f32 v24, v24
v_exp_f32 v25, v25
v_exp_f32 v26, v26
v_exp_f32 v27, v27
s_nop 0
v_mul_f32 v169, v24, v17
v_fmac_f32 v169, v25, v19
v_fmac_f32 v169, v26, v21
v_fmac_f32 v169, v27, v23
buffer_store_dwordx2 v[168:169], v7, s[28:31], s61 offen offset:2048 sc1
s_waitcnt lgkmcnt(6)
v_mul_f32 v160, v24, v48
v_mul_f32 v161, v24, v49
v_mul_f32 v162, v24, v50
v_mul_f32 v163, v24, v51
v_mul_f32 v164, v24, v52
v_mul_f32 v165, v24, v53
v_mul_f32 v166, v24, v54
v_mul_f32 v167, v24, v55
s_waitcnt lgkmcnt(4)
v_fmac_f32 v160, v25, v56
v_fmac_f32 v161, v25, v57
v_fmac_f32 v162, v25, v58
v_fmac_f32 v163, v25, v59
v_fmac_f32 v164, v25, v60
v_fmac_f32 v165, v25, v61
v_fmac_f32 v166, v25, v62
v_fmac_f32 v167, v25, v63
s_waitcnt lgkmcnt(2)
v_fmac_f32 v160, v26, v64
v_fmac_f32 v161, v26, v65
v_fmac_f32 v162, v26, v66
v_fmac_f32 v163, v26, v67
v_fmac_f32 v164, v26, v68
v_fmac_f32 v165, v26, v69
v_fmac_f32 v166, v26, v70
v_fmac_f32 v167, v26, v71
s_waitcnt lgkmcnt(0)
v_fmac_f32 v160, v27, v72
v_fmac_f32 v161, v27, v73
v_fmac_f32 v162, v27, v74
v_fmac_f32 v163, v27, v75
v_fmac_f32 v164, v27, v76
v_fmac_f32 v165, v27, v77
v_fmac_f32 v166, v27, v78
v_fmac_f32 v167, v27, v79
buffer_store_dwordx4 v[160:163], v7, s[28:31], s61 offen sc1
buffer_store_dwordx4 v[164:167], v7, s[28:31], s61 offen offset:1024 sc1
s_waitcnt vmcnt(0)
s_mov_b64 exec, 1
buffer_atomic_add v204, v205, s[32:35], 0 offen sc0
s_mov_b64 exec, -1
s_waitcnt vmcnt(0)
v_readfirstlane_b32 s64, v204
s_cmp_lg_u32 s64, 7
s_cbranch_scc1 L_end
s_add_u32 s62, s60, 0
buffer_load_dwordx2 v[16:17], v7, s[28:31], s62 offen offset:2048 sc1
s_add_u32 s62, s60, 4096
buffer_load_dwordx2 v[18:19], v7, s[28:31], s62 offen offset:2048 sc1
s_add_u32 s62, s60, 8192
buffer_load_dwordx2 v[20:21], v7, s[28:31], s62 offen offset:2048 sc1
s_add_u32 s62, s60, 12288
buffer_load_dwordx2 v[22:23], v7, s[28:31], s62 offen offset:2048 sc1
s_add_u32 s62, s60, 16384
buffer_load_dwordx2 v[24:25], v7, s[28:31], s62 offen offset:2048 sc1
s_add_u32 s62, s60, 20480
buffer_load_dwordx2 v[26:27], v7, s[28:31], s62 offen offset:2048 sc1
s_add_u32 s62, s60, 24576
buffer_load_dwordx2 v[28:29], v7, s[28:31], s62 offen offset:2048 sc1
s_add_u32 s62, s60, 28672
buffer_load_dwordx2 v[30:31], v7, s[28:31], s62 offen offset:2048 sc1
s_add_u32 s62, s60, 0
buffer_load_dwordx4 v[48:51], v7, s[28:31], s62 offen sc1
buffer_load_dwordx4 v[52:55], v7, s[28:31], s62 offen offset:1024 sc1
s_add_u32 s62, s60, 4096
buffer_load_dwordx4 v[56:59], v7, s[28:31], s62 offen sc1
buffer_load_dwordx4 v[60:63], v7, s[28:31], s62 offen offset:1024 sc1
s_add_u32 s62, s60, 8192
buffer_load_dwordx4 v[64:67], v7, s[28:31], s62 offen sc1
buffer_load_dwordx4 v[68:71], v7, s[28:31], s62 offen offset:1024 sc1
s_add_u32 s62, s60, 12288
buffer_load_dwordx4 v[72:75], v7, s[28:31], s62 offen sc1
buffer_load_dwordx4 v[76:79], v7, s[28:31], s62 offen offset:1024 sc1
s_add_u32 s62, s60, 16384
buffer_load_dwordx4 v[80:83], v7, s[28:31], s62 offen sc1
buffer_load_dwordx4 v[84:87], v7, s[28:31], s62 offen offset:1024 sc1
s_add_u32 s62, s60, 20480
buffer_load_dwordx4 v[88:91], v7, s[28:31], s62 offen sc1
buffer_load_dwordx4 v[92:95], v7, s[28:31], s62 offen offset:1024 sc1
s_add_u32 s62, s60, 24576
buffer_load_dwordx4 v[96:99], v7, s[28:31], s62 offen sc1
buffer_load_dwordx4 v[100:103], v7, s[28:31], s62 offen offset:1024 sc1
s_add_u32 s62, s60, 28672
buffer_load_dwordx4 v[104:107], v7, s[28:31], s62 offen sc1
buffer_load_dwordx4 v[108:111], v7, s[28:31], s62 offen offset:1024 sc1
s_lshl_b32 s60, s45, 10
s_waitcnt vmcnt(16)
v_max3_f32 v9, v16, v18, v20
v_max3_f32 v9, v9, v22, v24
v_max3_f32 v9, v9, v26, v28
v_max_f32 v9, v9, v30
v_sub_f32 v32, v16, v9
v_sub_f32 v33, v18, v9
v_sub_f32 v34, v20, v9
v_sub_f32 v35, v22, v9
v_sub_f32 v36, v24, v9
v_sub_f32 v37, v26, v9
v_sub_f32 v38, v28, v9
v_sub_f32 v39, v30, v9
v_exp_f32 v32, v32
v_exp_f32 v33, v33
v_exp_f32 v34, v34
v_exp_f32 v35, v35
v_exp_f32 v36, v36
v_exp_f32 v37, v37
v_exp_f32 v38, v38
v_exp_f32 v39, v39
s_nop 0
v_mul_f32 v169, v32, v17
v_fmac_f32 v169, v33, v19
v_fmac_f32 v169, v34, v21
v_fmac_f32 v169, v35, v23
v_fmac_f32 v169, v36, v25
v_fmac_f32 v169, v37, v27
v_fmac_f32 v169, v38, v29
v_fmac_f32 v169, v39, v31
v_rcp_f32 v169, v169
s_nop 0
v_mul_f32 v32, v32, v169
v_mul_f32 v33, v33, v169
v_mul_f32 v34, v34, v169
v_mul_f32 v35, v35, v169
v_mul_f32 v36, v36, v169
v_mul_f32 v37, v37, v169
v_mul_f32 v38, v38, v169
v_mul_f32 v39, v39, v169
s_waitcnt vmcnt(14)
v_mul_f32 v160, v32, v48
v_mul_f32 v161, v32, v49
v_mul_f32 v162, v32, v50
v_mul_f32 v163, v32, v51
v_mul_f32 v164, v32, v52
v_mul_f32 v165, v32, v53
v_mul_f32 v166, v32, v54
v_mul_f32 v167, v32, v55
s_waitcnt vmcnt(12)
v_fmac_f32 v160, v33, v56
v_fmac_f32 v161, v33, v57
v_fmac_f32 v162, v33, v58
v_fmac_f32 v163, v33, v59
v_fmac_f32 v164, v33, v60
v_fmac_f32 v165, v33, v61
v_fmac_f32 v166, v33, v62
v_fmac_f32 v167, v33, v63
s_waitcnt vmcnt(10)
v_fmac_f32 v160, v34, v64
v_fmac_f32 v161, v34, v65
v_fmac_f32 v162, v34, v66
v_fmac_f32 v163, v34, v67
v_fmac_f32 v164, v34, v68
v_fmac_f32 v165, v34, v69
v_fmac_f32 v166, v34, v70
v_fmac_f32 v167, v34, v71
s_waitcnt vmcnt(8)
v_fmac_f32 v160, v35, v72
v_fmac_f32 v161, v35, v73
v_fmac_f32 v162, v35, v74
v_fmac_f32 v163, v35, v75
v_fmac_f32 v164, v35, v76
v_fmac_f32 v165, v35, v77
v_fmac_f32 v166, v35, v78
v_fmac_f32 v167, v35, v79
s_waitcnt vmcnt(6)
v_fmac_f32 v160, v36, v80
v_fmac_f32 v161, v36, v81
v_fmac_f32 v162, v36, v82
v_fmac_f32 v163, v36, v83
v_fmac_f32 v164, v36, v84
v_fmac_f32 v165, v36, v85
v_fmac_f32 v166, v36, v86
v_fmac_f32 v167, v36, v87
s_waitcnt vmcnt(4)
v_fmac_f32 v160, v37, v88
v_fmac_f32 v161, v37, v89
v_fmac_f32 v162, v37, v90
v_fmac_f32 v163, v37, v91
v_fmac_f32 v164, v37, v92
v_fmac_f32 v165, v37, v93
v_fmac_f32 v166, v37, v94
v_fmac_f32 v167, v37, v95
s_waitcnt vmcnt(2)
v_fmac_f32 v160, v38, v96
v_fmac_f32 v161, v38, v97
v_fmac_f32 v162, v38, v98
v_fmac_f32 v163, v38, v99
v_fmac_f32 v164, v38, v100
v_fmac_f32 v165, v38, v101
v_fmac_f32 v166, v38, v102
v_fmac_f32 v167, v38, v103
s_waitcnt vmcnt(0)
v_fmac_f32 v160, v39, v104
v_fmac_f32 v161, v39, v105
v_fmac_f32 v162, v39, v106
v_fmac_f32 v163, v39, v107
v_fmac_f32 v164, v39, v108
v_fmac_f32 v165, v39, v109
v_fmac_f32 v166, v39, v110
v_fmac_f32 v167, v39, v111
v_cvt_pk_bf16_f32 v160, v160, v161
v_cvt_pk_bf16_f32 v161, v162, v163
v_cvt_pk_bf16_f32 v162, v164, v165
v_cvt_pk_bf16_f32 v163, v166, v167
buffer_store_dwordx4 v[160:163], v7, s[36:39], s60 offen
L_end:
s_endpgm
.section .rodata,"a"
.p2align 6
.amdhsa_kernel standalone__gqa_softmax__decode_kernel
  .amdhsa_next_free_vgpr 210
  .amdhsa_next_free_sgpr 100
  .amdhsa_accum_offset 212
  .amdhsa_group_segment_fixed_size 0
  .amdhsa_kernarg_size 48
  .amdhsa_user_sgpr_count 2
  .amdhsa_user_sgpr_kernarg_segment_ptr 1
  .amdhsa_system_sgpr_workgroup_id_x 1
  .amdhsa_float_denorm_mode_32 3
.end_amdhsa_kernel
```
